```python
import torch

def _softmax(x, axis=-1):
    return torch.softmax(x, dim=axis)
def _gelu(x):
    return torch.nn.functional.gelu(x, approximate="tanh")
def _silu(x):
    return torch.nn.functional.silu(x)
def _sigmoid(x):
    return torch.sigmoid(x)
def _layernorm(x, axis=-1, eps=1e-5):
    m = x.mean(dim=axis, keepdim=True)
    v = x.var(dim=axis, keepdim=True, unbiased=False)
    return (x - m) / torch.sqrt(v + eps)
def _scatter_add(tgt, idx, src, axis=0):
    return tgt.clone().index_add_(axis, idx, src)
def _segment_sum(src, seg, n):
    out = torch.zeros((n,) + src.shape[1:], dtype=src.dtype)
    return out.index_add_(0, seg, src)
def _pad(x, pw):
    flat = tuple(v for pair in reversed(pw) for v in pair)
    return torch.nn.functional.pad(x, flat)

kernel_name = 'gated_mix__sliding_block_cached__mixer_channel_mlp__decode'

def setup_inputs():

    _w = (lambda a: (lambda t: t.to(torch.bfloat16) if t.is_floating_point() else t)(torch.as_tensor(a)))
    def _A_setup():
        B, Sq, D = 4, 1, 512
        Hq, Hkv, Sk, Dh = 32, 8, 4096, 128
        assert Hq % Hkv == 0, (Hq, Hkv)
        return {
            "x": _w((lambda *s: torch.randn(*s, dtype=torch.bfloat16) * 0.05)(B, Sq, D)),
            "k_cache": _w((lambda *s: torch.randn(*s, dtype=torch.bfloat16) * 6.4)(B, Hkv, Sk, Dh)),
            "v_cache": _w((lambda *s: torch.randn(*s, dtype=torch.bfloat16) * 0.4)(B, Hkv, Sk, Dh)),
            "wq": _w((lambda *s: torch.randn(*s, dtype=torch.bfloat16) * 6.4)(D, Hq * Dh) * (D ** -0.5)),
            "wo": _w((lambda *s: torch.randn(*s, dtype=torch.bfloat16) * 0.4)(Hq * Dh, D) * ((Hq * Dh) ** -0.5)),
        }
    _A_in = _A_setup()

    def _B_setup():
        B, S, D, F = 4, 1, 512, 1792
        return {
            "x": _w((lambda *s: torch.randn(*s, dtype=torch.bfloat16) * 0.05)(B, S, D)),
            "w1": _w((lambda *s: torch.randn(*s, dtype=torch.bfloat16) * 0.8)(D, F) * (D ** -0.5)),
            "b1": _w((lambda *s: torch.randn(*s, dtype=torch.bfloat16) * 0.8)(F)),
            "w2": _w((lambda *s: torch.randn(*s, dtype=torch.bfloat16) * 0.05)(F, D) * (F ** -0.5)),
            "b2": _w((lambda *s: torch.randn(*s, dtype=torch.bfloat16) * 0.05)(D)),
        }
    _B_in = _B_setup()

    return {
        "A_x": _A_in["x"],
        "A_k_cache": _A_in["k_cache"],
        "A_v_cache": _A_in["v_cache"],
        "A_wq": _A_in["wq"],
        "A_wo": _A_in["wo"],
        "B_x": _B_in["x"],
        "B_w1": _B_in["w1"],
        "B_b1": _B_in["b1"],
        "B_w2": _B_in["w2"],
        "B_b2": _B_in["b2"],
        "gate_w": _w((lambda *s: torch.randn(*s, dtype=torch.bfloat16) * 0.05)(512) * 16.0),
    }

def reference(A_x, A_k_cache, A_v_cache, A_wq, A_wo, B_x, B_w1, B_b1, B_w2, B_b2, gate_w):
    def _A_ref(x, k_cache, v_cache, wq, wo):
        B, Sq, D = x.shape
        Hq, Dh = 32, 128
        Hkv, Sk = k_cache.shape[1], k_cache.shape[2]
        W = min(4096, max(256, Sk // 4))
        rep = Hq // Hkv
        q = (lambda x, *d: x.permute(*d))((x @ wq).reshape(B, Sq, Hq, Dh), 0, 2, 1, 3)
        k = (lambda x, n, axis: torch.repeat_interleave(x, n, dim=axis))(k_cache[:, :, Sk - W:, :], rep, axis=1)
        v = (lambda x, n, axis: torch.repeat_interleave(x, n, dim=axis))(v_cache[:, :, Sk - W:, :], rep, axis=1)
        scores = torch.einsum("bhqd,bhkd->bhqk", q, k) * (Dh ** -0.5)
        p = _softmax(scores, axis=-1)
        o = torch.einsum("bhqk,bhkd->bhqd", p, v)
        return (lambda x, *d: x.permute(*d))(o, 0, 2, 1, 3).reshape(B, Sq, Hq * Dh) @ wo

    def _B_ref(x, w1, b1, w2, b2):
        y = _layernorm(x, axis=-1)
        h = _gelu(torch.einsum("bsd,df->bsf", y, w1) + b1)
        return torch.einsum("bsf,fd->bsd", h, w2) + b2

    x = A_x
    g = _sigmoid((x * gate_w).sum(-1, keepdims=True))
    a = _A_ref(x, A_k_cache, A_v_cache, A_wq, A_wo)
    b = _B_ref(x, B_w1, B_b1, B_w2, B_b2)
    return g * a + (1 - g) * b
```

```asm
; @launch grid=(256,1,1) block=(256,1,1) lds=135168
.amdgcn_target "amdgcn-amd-amdhsa--gfx950"
.text
.globl gated_mix__sliding_block_cached__mixer_channel_mlp__decode_kernel
.p2align 8
.type gated_mix__sliding_block_cached__mixer_channel_mlp__decode_kernel,@function
gated_mix__sliding_block_cached__mixer_channel_mlp__decode_kernel:
    s_cmp_ge_u32 s2, 256
    s_cbranch_scc1 L_end
    s_load_dwordx16 s[16:31], s[0:1], 0
    s_load_dwordx8 s[32:39], s[0:1], 64
    s_load_dwordx4 s[40:43], s[0:1], 96
    v_and_b32 v1, 63, v0
    v_lshrrev_b32 v5, 6, v0
    v_lshrrev_b32 v2, 4, v1
    v_and_b32 v3, 15, v0
    v_and_b32 v4, 3, v0
    v_readfirstlane_b32 s8, v5
    v_bfe_u32 v19, v0, 2, 2
    s_and_b32 s4, s2, 7
    s_lshr_b32 s5, s2, 3
    s_lshr_b32 s6, s5, 3
    s_and_b32 s7, s5, 7
    s_lshl_b32 s9, s4, 3
    s_add_u32 s9, s9, s7
    s_mov_b32 s10, s6
    s_waitcnt lgkmcnt(0)
    s_load_dword s11, s[42:43], 0
    s_mov_b32 s44, s16
    s_and_b32 s45, s17, 0xffff
    s_mov_b32 s46, 4096
    s_mov_b32 s47, 0x00020000
    s_mov_b32 s48, s18
    s_and_b32 s49, s19, 0xffff
    s_mov_b32 s50, 33554432
    s_mov_b32 s51, 0x00020000
    s_mov_b32 s52, s20
    s_and_b32 s53, s21, 0xffff
    s_mov_b32 s54, 33554432
    s_mov_b32 s55, 0x00020000
    s_mov_b32 s56, s22
    s_and_b32 s57, s23, 0xffff
    s_mov_b32 s58, 4194304
    s_mov_b32 s59, 0x00020000
    s_mov_b32 s60, s24
    s_and_b32 s61, s25, 0xffff
    s_mov_b32 s62, 4194304
    s_mov_b32 s63, 0x00020000
    s_mov_b32 s64, s28
    s_and_b32 s65, s29, 0xffff
    s_mov_b32 s66, 1835008
    s_mov_b32 s67, 0x00020000
    s_mov_b32 s68, s30
    s_and_b32 s69, s31, 0xffff
    s_mov_b32 s70, 3584
    s_mov_b32 s71, 0x00020000
    s_mov_b32 s72, s32
    s_and_b32 s73, s33, 0xffff
    s_mov_b32 s74, 1835008
    s_mov_b32 s75, 0x00020000
    s_mov_b32 s76, s34
    s_and_b32 s77, s35, 0xffff
    s_mov_b32 s78, 1024
    s_mov_b32 s79, 0x00020000
    s_mov_b32 s80, s36
    s_and_b32 s81, s37, 0xffff
    s_mov_b32 s82, 1024
    s_mov_b32 s83, 0x00020000
    s_mov_b32 s84, s38
    s_and_b32 s85, s39, 0xffff
    s_mov_b32 s86, 4096
    s_mov_b32 s87, 0x00020000
    s_mov_b32 s88, s42
    s_and_b32 s89, s43, 0xffff
    s_mov_b32 s90, 4325376
    s_mov_b32 s91, 0x00020000
    v_lshlrev_b32 v10, 4, v1
    s_lshl_b32 s13, s8, 10
    s_add_u32 s18, s13, 128000
    s_mov_b32 m0, s18
    s_nop 0
    buffer_load_dwordx4 v10, s[44:47], s13 offen lds
    s_mov_b32 s13, 0
    s_mov_b32 s18, 132096
    s_mov_b32 m0, s18
    s_nop 0
    buffer_load_dwordx4 v10, s[80:83], s13 offen lds
    s_mul_i32 s13, s9, 56
    v_lshlrev_b32 v11, 1, v1
    buffer_load_ushort v17, v11, s[68:71], s13 offen
    s_lshl_b32 s13, s10, 8
    s_lshl_b32 s14, s9, 2
    s_add_u32 s13, s13, s14
    v_and_b32 v11, 1, v19
    v_lshlrev_b32 v11, 1, v11
    buffer_load_ushort v18, v11, s[76:79], s13 offen
    v_lshrrev_b32 v5, 3, v1
    v_and_b32 v6, 7, v1
    v_lshrrev_b32 v7, 4, v1
    v_and_b32 v7, 1, v7
    v_lshlrev_b32 v7, 1, v7
    v_xor_b32 v6, v6, v7
    v_xor_b32 v7, 4, v6
    v_lshlrev_b32 v8, 13, v5
    v_lshl_add_u32 v9, v7, 4, v8
    v_lshl_add_u32 v8, v6, 4, v8
    s_lshl_b32 s16, s6, 20
    s_lshl_b32 s17, s8, 18
    s_add_u32 s16, s16, s17
    s_lshl_b32 s17, s9, 7
    s_add_u32 s16, s16, s17
    s_lshl_b32 s18, s8, 12
    s_mov_b32 m0, s18
    s_nop 0
    buffer_load_dwordx4 v8, s[56:59], s16 offen nt lds
    s_add_u32 s16, s16, 65536
    s_add_u32 s18, s18, 1024
    s_mov_b32 m0, s18
    s_nop 0
    buffer_load_dwordx4 v9, s[56:59], s16 offen nt lds
    s_add_u32 s16, s16, 65536
    s_add_u32 s18, s18, 1024
    s_mov_b32 m0, s18
    s_nop 0
    buffer_load_dwordx4 v8, s[56:59], s16 offen nt lds
    s_add_u32 s16, s16, 65536
    s_add_u32 s18, s18, 1024
    s_mov_b32 m0, s18
    s_nop 0
    buffer_load_dwordx4 v9, s[56:59], s16 offen nt lds
    s_min_u32 s14, s5, 27
    s_mov_b32 s15, 3584
    v_mul_lo_u32 v8, v5, s15
    v_lshl_add_u32 v9, v7, 4, v8
    v_lshl_add_u32 v8, v6, 4, v8
    s_mul_i32 s16, s4, 229376
    s_mul_i32 s17, s8, 57344
    s_add_u32 s16, s16, s17
    s_lshl_b32 s17, s14, 7
    s_add_u32 s16, s16, s17
    s_lshl_b32 s18, s8, 11
    s_add_u32 s18, s18, 16384
    s_mov_b32 m0, s18
    s_nop 0
    buffer_load_dwordx4 v8, s[64:67], s16 offen nt lds
    s_add_u32 s16, s16, 28672
    s_add_u32 s18, s18, 1024
    s_mov_b32 m0, s18
    s_nop 0
    buffer_load_dwordx4 v9, s[64:67], s16 offen nt lds
    s_lshl_b32 s16, s6, 3
    s_add_u32 s16, s16, s4
    s_lshl_b32 s16, s16, 12
    s_lshl_b32 s17, s7, 7
    s_add_u32 s16, s16, s17
    s_lshl_b32 s17, s8, 5
    s_add_u32 s16, s16, s17
    s_add_u32 s16, s16, 3072
    s_lshl_b32 s16, s16, 8
    s_mov_b32 s17, s16
    v_xor_b32 v5, v3, v2
    v_lshlrev_b32 v5, 4, v5
    v_lshl_add_u32 v5, v2, 8, v5
    v_xor_b32 v6, 64, v5
    v_xor_b32 v7, 0x80, v5
    v_xor_b32 v8, 0xc0, v5
    s_lshl_b32 s18, s8, 13
    s_add_u32 s18, s18, 24576
    s_mov_b32 m0, s18
    s_nop 0
    buffer_load_dwordx4 v5, s[48:51], s16 offen nt lds
    s_add_u32 s16, s16, 1024
    s_add_u32 s18, s18, 1024
    s_mov_b32 m0, s18
    s_nop 0
    buffer_load_dwordx4 v6, s[48:51], s16 offen nt lds
    s_add_u32 s16, s16, 1024
    s_add_u32 s18, s18, 1024
    s_mov_b32 m0, s18
    s_nop 0
    buffer_load_dwordx4 v7, s[48:51], s16 offen nt lds
    s_add_u32 s16, s16, 1024
    s_add_u32 s18, s18, 1024
    s_mov_b32 m0, s18
    s_nop 0
    buffer_load_dwordx4 v8, s[48:51], s16 offen nt lds
    s_add_u32 s16, s16, 1024
    s_add_u32 s18, s18, 1024
    s_mov_b32 m0, s18
    s_nop 0
    buffer_load_dwordx4 v5, s[48:51], s16 offen nt lds
    s_add_u32 s16, s16, 1024
    s_add_u32 s18, s18, 1024
    s_mov_b32 m0, s18
    s_nop 0
    buffer_load_dwordx4 v6, s[48:51], s16 offen nt lds
    s_add_u32 s16, s16, 1024
    s_add_u32 s18, s18, 1024
    s_mov_b32 m0, s18
    s_nop 0
    buffer_load_dwordx4 v7, s[48:51], s16 offen nt lds
    s_add_u32 s16, s16, 1024
    s_add_u32 s18, s18, 1024
    s_mov_b32 m0, s18
    s_nop 0
    buffer_load_dwordx4 v8, s[48:51], s16 offen nt lds
    s_lshl_b32 s16, s6, 3
    s_add_u32 s16, s16, s4
    s_lshl_b32 s16, s16, 12
    s_lshl_b32 s17, s7, 7
    s_add_u32 s16, s16, s17
    s_lshl_b32 s17, s8, 5
    s_add_u32 s16, s16, s17
    s_add_u32 s16, s16, 3072
    s_lshl_b32 s16, s16, 8
    s_mov_b32 s17, s16
    v_lshlrev_b32 v7, 1, v2
    v_xor_b32 v5, v3, v7
    v_xor_b32 v6, 8, v5
    v_lshlrev_b32 v5, 4, v5
    v_lshlrev_b32 v6, 4, v6
    v_lshl_add_u32 v5, v2, 8, v5
    v_lshl_add_u32 v6, v2, 8, v6
    s_lshl_b32 s18, s8, 13
    s_add_u32 s18, s18, 57344
    s_mov_b32 m0, s18
    s_nop 0
    buffer_load_dwordx4 v5, s[52:55], s17 offen nt lds
    s_add_u32 s17, s17, 1024
    s_add_u32 s18, s18, 1024
    s_mov_b32 m0, s18
    s_nop 0
    buffer_load_dwordx4 v6, s[52:55], s17 offen nt lds
    s_add_u32 s17, s17, 1024
    s_add_u32 s18, s18, 1024
    s_mov_b32 m0, s18
    s_nop 0
    buffer_load_dwordx4 v5, s[52:55], s17 offen nt lds
    s_add_u32 s17, s17, 1024
    s_add_u32 s18, s18, 1024
    s_mov_b32 m0, s18
    s_nop 0
    buffer_load_dwordx4 v6, s[52:55], s17 offen nt lds
    s_add_u32 s17, s17, 1024
    s_add_u32 s18, s18, 1024
    s_mov_b32 m0, s18
    s_nop 0
    buffer_load_dwordx4 v5, s[52:55], s17 offen nt lds
    s_add_u32 s17, s17, 1024
    s_add_u32 s18, s18, 1024
    s_mov_b32 m0, s18
    s_nop 0
    buffer_load_dwordx4 v6, s[52:55], s17 offen nt lds
    s_add_u32 s17, s17, 1024
    s_add_u32 s18, s18, 1024
    s_mov_b32 m0, s18
    s_nop 0
    buffer_load_dwordx4 v5, s[52:55], s17 offen nt lds
    s_add_u32 s17, s17, 1024
    s_add_u32 s18, s18, 1024
    s_mov_b32 m0, s18
    s_nop 0
    buffer_load_dwordx4 v6, s[52:55], s17 offen nt lds
    s_lshl_b32 s26, s6, 15
    s_lshl_b32 s14, s4, 12
    s_add_u32 s26, s26, s14
    s_add_u32 s26, s26, 65536
    s_add_u32 s27, s26, 0x20000
    s_add_u32 s28, s26, 0x40000
    s_add_u32 s29, s26, 0x60000
    s_lshl_b32 s30, s6, 17
    s_lshl_b32 s14, s9, 9
    s_add_u32 s30, s30, s14
    s_lshl_b32 s14, s8, 7
    s_add_u32 s30, s30, s14
    s_add_u32 s30, s30, 65536
    s_lshl_b32 s31, s4, 16
    s_lshl_b32 s15, s5, 9
    s_add_u32 s31, s31, s15
    s_add_u32 s31, s31, s14
    s_add_u32 s31, s31, 589824
    s_lshl_b32 s13, s6, 3
    s_add_u32 s13, s13, s4
    s_lshl_b32 s32, s13, 3
    s_add_u32 s32, s32, s7
    s_lshl_b32 s32, s32, 12
    s_lshl_b32 s16, s8, 10
    s_add_u32 s32, s32, s16
    s_add_u32 s32, s32, 1179648
    s_lshl_b32 s33, s13, 2
    s_add_u32 s33, s33, s8
    s_lshl_b32 s33, s33, 3
    s_add_u32 s33, s33, s7
    s_lshl_b32 s33, s33, 4
    s_add_u32 s33, s33, 1114112
    s_lshl_b32 s13, s8, 3
    s_add_u32 s13, s13, s4
    s_lshr_b32 s17, s7, 1
    s_lshl_b32 s34, s13, 15
    s_lshl_b32 s16, s17, 10
    s_add_u32 s34, s34, s16
    s_and_b32 s16, s7, 1
    s_lshl_b32 s16, s16, 9
    s_add_u32 s34, s34, s16
    s_add_u32 s34, s34, 1179648
    s_lshl_b32 s35, s13, 2
    s_add_u32 s35, s35, s17
    s_lshl_b32 s35, s35, 7
    s_add_u32 s35, s35, 1114112
    s_mul_i32 s36, s9, 224
    s_lshl_b32 s14, s8, 14
    s_add_u32 s36, s36, s14
    s_add_u32 s36, s36, 589824
    s_lshl_b32 s37, s10, 19
    s_lshl_b32 s15, s8, 17
    s_add_u32 s39, s37, 2228224
    s_add_u32 s37, s37, s15
    s_lshl_b32 s15, s9, 7
    s_add_u32 s37, s37, s15
    s_add_u32 s37, s37, 2228224
    s_add_u32 s38, s37, 65536
    s_lshl_b32 s15, s9, 13
    s_add_u32 s39, s39, s15
    s_lshl_b32 s15, s8, 11
    s_add_u32 s39, s39, s15
    v_lshlrev_b32 v244, 15, v2
    v_lshl_add_u32 v244, v3, 3, v244
    v_lshlrev_b32 v245, 14, v2
    v_lshl_add_u32 v245, v3, 3, v245
    v_lshlrev_b32 v246, 4, v0
    v_lshlrev_b32 v247, 4, v1
    v_lshlrev_b32 v248, 3, v1
    v_lshlrev_b32 v249, 5, v1
    v_mov_b32 v250, 0
    v_lshrrev_b32 v251, 1, v3
    v_lshlrev_b32 v251, 13, v251
    v_and_b32 v6, 1, v3
    v_lshl_add_u32 v251, v6, 6, v251
    v_lshl_add_u32 v251, v2, 4, v251
    v_cmp_eq_u32 s[20:21], 1, v2
    v_cmp_eq_u32 s[22:23], 2, v2
    v_cmp_eq_u32 s[24:25], 3, v2
    s_waitcnt lgkmcnt(0)
    s_add_u32 s11, s11, 1
    v_lshl_add_u32 v9, v2, 3, v19
    v_lshlrev_b32 v10, 7, v9
    v_lshl_add_u32 v10, v4, 3, v10
    v_lshrrev_b32 v11, 1, v19
    v_and_b32 v12, 1, v2
    v_lshl_or_b32 v11, v12, 1, v11
    v_xor_b32 v11, s8, v11
    v_lshl_add_u32 v10, v11, 5, v10
    v_mov_b32 v243, v10
    v_lshlrev_b32 v10, 10, v4
    v_lshl_add_u32 v10, v2, 4, v10
    s_lshl_b32 s13, s6, 8
    s_add_u32 s13, s13, 128000
    v_add_u32 v11, s13, v10
    s_lshl_b32 s13, s4, 7
    s_add_u32 s13, s13, 128000
    v_add_u32 v10, s13, v10
    v_lshrrev_b32 v12, 2, v1
    v_lshlrev_b32 v12, 6, v12
    v_lshl_add_u32 v13, v4, 10, v12
    v_add_u32 v13, 128000, v13
    v_add_u32 v12, 132096, v12
    s_waitcnt vmcnt(24)
    s_barrier
    ds_read_b128 v[44:47], v13 offset:0
    ds_read_b128 v[48:51], v13 offset:16
    ds_read_b128 v[52:55], v13 offset:32
    ds_read_b128 v[56:59], v13 offset:48
    ds_read_b128 v[60:63], v12 offset:0
    ds_read_b128 v[64:67], v12 offset:16
    ds_read_b128 v[68:71], v12 offset:32
    ds_read_b128 v[72:75], v12 offset:48
    ds_read_b128 v[36:39], v10 offset:0
    ds_read_b128 v[40:43], v10 offset:64
    ds_read_b128 v[20:23], v11 offset:0
    ds_read_b128 v[24:27], v11 offset:64
    ds_read_b128 v[28:31], v11 offset:128
    ds_read_b128 v[32:35], v11 offset:192
    s_waitcnt lgkmcnt(0)
    v_mov_b32 v10, v243
    s_waitcnt vmcnt(16)
    s_barrier
    ds_read_b64_tr_b16 v[156:157], v10 offset:0
    ds_read_b64_tr_b16 v[158:159], v10 offset:512
    ds_read_b64_tr_b16 v[160:161], v10 offset:4096
    ds_read_b64_tr_b16 v[162:163], v10 offset:4608
    ds_read_b64_tr_b16 v[164:165], v10 offset:8192
    ds_read_b64_tr_b16 v[166:167], v10 offset:8704
    ds_read_b64_tr_b16 v[168:169], v10 offset:12288
    ds_read_b64_tr_b16 v[170:171], v10 offset:12800
    v_mov_b32 v225, s11
    s_waitcnt lgkmcnt(0)
    v_mfma_f32_16x16x32_bf16 v[220:223], v[20:23], v[156:159], 0
    v_mfma_f32_16x16x32_bf16 v[220:223], v[24:27], v[160:163], v[220:223]
    v_mfma_f32_16x16x32_bf16 v[220:223], v[28:31], v[164:167], v[220:223]
    v_mfma_f32_16x16x32_bf16 v[220:223], v[32:35], v[168:171], v[220:223]
    s_nop 7
    v_cndmask_b32 v224, v220, v221, s[20:21]
    v_cndmask_b32 v224, v224, v222, s[22:23]
    v_cndmask_b32 v224, v224, v223, s[24:25]
    buffer_store_dwordx2 v[224:225], v244, s[88:91], s30 offen sc1
    v_lshlrev_b32 v156, 16, v44
    v_and_b32 v157, 0xffff0000, v44
    v_lshlrev_b32 v158, 16, v45
    v_and_b32 v159, 0xffff0000, v45
    v_lshlrev_b32 v160, 16, v46
    v_and_b32 v161, 0xffff0000, v46
    v_lshlrev_b32 v162, 16, v47
    v_and_b32 v163, 0xffff0000, v47
    v_lshlrev_b32 v164, 16, v48
    v_and_b32 v165, 0xffff0000, v48
    v_lshlrev_b32 v166, 16, v49
    v_and_b32 v167, 0xffff0000, v49
    v_lshlrev_b32 v168, 16, v50
    v_and_b32 v169, 0xffff0000, v50
    v_lshlrev_b32 v170, 16, v51
    v_and_b32 v171, 0xffff0000, v51
    v_lshlrev_b32 v172, 16, v52
    v_and_b32 v173, 0xffff0000, v52
    v_lshlrev_b32 v174, 16, v53
    v_and_b32 v175, 0xffff0000, v53
    v_lshlrev_b32 v176, 16, v54
    v_and_b32 v177, 0xffff0000, v54
    v_lshlrev_b32 v178, 16, v55
    v_and_b32 v179, 0xffff0000, v55
    v_lshlrev_b32 v180, 16, v56
    v_and_b32 v181, 0xffff0000, v56
    v_lshlrev_b32 v182, 16, v57
    v_and_b32 v183, 0xffff0000, v57
    v_lshlrev_b32 v184, 16, v58
    v_and_b32 v185, 0xffff0000, v58
    v_lshlrev_b32 v186, 16, v59
    v_and_b32 v187, 0xffff0000, v59
    v_pk_add_f32 v[12:13], v[156:157], v[158:159]
    v_pk_add_f32 v[12:13], v[12:13], v[160:161]
    v_pk_add_f32 v[12:13], v[12:13], v[162:163]
    v_pk_add_f32 v[12:13], v[12:13], v[164:165]
    v_pk_add_f32 v[12:13], v[12:13], v[166:167]
    v_pk_add_f32 v[12:13], v[12:13], v[168:169]
    v_pk_add_f32 v[12:13], v[12:13], v[170:171]
    v_pk_add_f32 v[12:13], v[12:13], v[172:173]
    v_pk_add_f32 v[12:13], v[12:13], v[174:175]
    v_pk_add_f32 v[12:13], v[12:13], v[176:177]
    v_pk_add_f32 v[12:13], v[12:13], v[178:179]
    v_pk_add_f32 v[12:13], v[12:13], v[180:181]
    v_pk_add_f32 v[12:13], v[12:13], v[182:183]
    v_pk_add_f32 v[12:13], v[12:13], v[184:185]
    v_pk_add_f32 v[12:13], v[12:13], v[186:187]
    v_add_f32 v12, v12, v13
    s_nop 1
    v_add_f32_dpp v12, v12, v12 row_ror:4 row_mask:0xf bank_mask:0xf
    s_nop 1
    v_add_f32_dpp v12, v12, v12 row_ror:8 row_mask:0xf bank_mask:0xf
    v_mov_b32 v14, v12
    s_nop 1
    v_permlane16_swap_b32 v12, v14
    v_add_f32 v12, v12, v14
    v_mov_b32 v14, v12
    s_nop 1
    v_permlane32_swap_b32 v12, v14
    v_add_f32 v12, v12, v14
    v_mul_f32 v12, 0x3b000000, v12
    v_mov_b32 v13, v12
    v_mov_b32 v10, 0
    v_mov_b32 v11, 0
    v_pk_add_f32 v[14:15], v[156:157], v[12:13] neg_lo:[0,1] neg_hi:[0,1]
    v_pk_fma_f32 v[10:11], v[14:15], v[14:15], v[10:11]
    v_pk_add_f32 v[14:15], v[158:159], v[12:13] neg_lo:[0,1] neg_hi:[0,1]
    v_pk_fma_f32 v[10:11], v[14:15], v[14:15], v[10:11]
    v_pk_add_f32 v[14:15], v[160:161], v[12:13] neg_lo:[0,1] neg_hi:[0,1]
    v_pk_fma_f32 v[10:11], v[14:15], v[14:15], v[10:11]
    v_pk_add_f32 v[14:15], v[162:163], v[12:13] neg_lo:[0,1] neg_hi:[0,1]
    v_pk_fma_f32 v[10:11], v[14:15], v[14:15], v[10:11]
    v_pk_add_f32 v[14:15], v[164:165], v[12:13] neg_lo:[0,1] neg_hi:[0,1]
    v_pk_fma_f32 v[10:11], v[14:15], v[14:15], v[10:11]
    v_pk_add_f32 v[14:15], v[166:167], v[12:13] neg_lo:[0,1] neg_hi:[0,1]
    v_pk_fma_f32 v[10:11], v[14:15], v[14:15], v[10:11]
    v_pk_add_f32 v[14:15], v[168:169], v[12:13] neg_lo:[0,1] neg_hi:[0,1]
    v_pk_fma_f32 v[10:11], v[14:15], v[14:15], v[10:11]
    v_pk_add_f32 v[14:15], v[170:171], v[12:13] neg_lo:[0,1] neg_hi:[0,1]
    v_pk_fma_f32 v[10:11], v[14:15], v[14:15], v[10:11]
    v_pk_add_f32 v[14:15], v[172:173], v[12:13] neg_lo:[0,1] neg_hi:[0,1]
    v_pk_fma_f32 v[10:11], v[14:15], v[14:15], v[10:11]
    v_pk_add_f32 v[14:15], v[174:175], v[12:13] neg_lo:[0,1] neg_hi:[0,1]
    v_pk_fma_f32 v[10:11], v[14:15], v[14:15], v[10:11]
    v_pk_add_f32 v[14:15], v[176:177], v[12:13] neg_lo:[0,1] neg_hi:[0,1]
    v_pk_fma_f32 v[10:11], v[14:15], v[14:15], v[10:11]
    v_pk_add_f32 v[14:15], v[178:179], v[12:13] neg_lo:[0,1] neg_hi:[0,1]
    v_pk_fma_f32 v[10:11], v[14:15], v[14:15], v[10:11]
    v_pk_add_f32 v[14:15], v[180:181], v[12:13] neg_lo:[0,1] neg_hi:[0,1]
    v_pk_fma_f32 v[10:11], v[14:15], v[14:15], v[10:11]
    v_pk_add_f32 v[14:15], v[182:183], v[12:13] neg_lo:[0,1] neg_hi:[0,1]
    v_pk_fma_f32 v[10:11], v[14:15], v[14:15], v[10:11]
    v_pk_add_f32 v[14:15], v[184:185], v[12:13] neg_lo:[0,1] neg_hi:[0,1]
    v_pk_fma_f32 v[10:11], v[14:15], v[14:15], v[10:11]
    v_pk_add_f32 v[14:15], v[186:187], v[12:13] neg_lo:[0,1] neg_hi:[0,1]
    v_pk_fma_f32 v[10:11], v[14:15], v[14:15], v[10:11]
    v_add_f32 v11, v10, v11
    s_nop 1
    v_add_f32_dpp v11, v11, v11 row_ror:4 row_mask:0xf bank_mask:0xf
    s_nop 1
    v_add_f32_dpp v11, v11, v11 row_ror:8 row_mask:0xf bank_mask:0xf
    v_mov_b32 v14, v11
    s_nop 1
    v_permlane16_swap_b32 v11, v14
    v_add_f32 v11, v11, v14
    v_mov_b32 v14, v11
    s_nop 1
    v_permlane32_swap_b32 v11, v14
    v_add_f32 v11, v11, v14
    v_mul_f32 v11, 0x3b000000, v11
    v_cvt_pk_bf16_f32 v14, v12, v12
    v_lshlrev_b32 v12, 16, v14
    v_cvt_pk_bf16_f32 v14, v11, v11
    v_lshlrev_b32 v11, 16, v14
    v_add_f32 v11, 0x3727c5ac, v11
    v_cvt_pk_bf16_f32 v14, v11, v11
    v_lshlrev_b32 v11, 16, v14
    v_sqrt_f32 v11, v11
    s_nop 0
    v_cvt_pk_bf16_f32 v14, v11, v11
    v_lshlrev_b32 v11, 16, v14
    v_rcp_f32 v9, v11
    v_lshlrev_b32 v14, 16, v36
    v_and_b32 v15, 0xffff0000, v36
    v_sub_f32 v14, v14, v12
    v_sub_f32 v15, v15, v12
    v_cvt_pk_bf16_f32 v14, v14, v15
    v_and_b32 v15, 0xffff0000, v14
    v_lshlrev_b32 v14, 16, v14
    v_mul_f32 v6, v14, v9
    v_mul_f32 v7, v15, v9
    v_fma_f32 v14, -v6, v11, v14
    v_fma_f32 v15, -v7, v11, v15
    v_fma_f32 v6, v14, v9, v6
    v_fma_f32 v7, v15, v9, v7
    v_cvt_pk_bf16_f32 v36, v6, v7
    v_lshlrev_b32 v14, 16, v37
    v_and_b32 v15, 0xffff0000, v37
    v_sub_f32 v14, v14, v12
    v_sub_f32 v15, v15, v12
    v_cvt_pk_bf16_f32 v14, v14, v15
    v_and_b32 v15, 0xffff0000, v14
    v_lshlrev_b32 v14, 16, v14
    v_mul_f32 v6, v14, v9
    v_mul_f32 v7, v15, v9
    v_fma_f32 v14, -v6, v11, v14
    v_fma_f32 v15, -v7, v11, v15
    v_fma_f32 v6, v14, v9, v6
    v_fma_f32 v7, v15, v9, v7
    v_cvt_pk_bf16_f32 v37, v6, v7
    v_lshlrev_b32 v14, 16, v38
    v_and_b32 v15, 0xffff0000, v38
    v_sub_f32 v14, v14, v12
    v_sub_f32 v15, v15, v12
    v_cvt_pk_bf16_f32 v14, v14, v15
    v_and_b32 v15, 0xffff0000, v14
    v_lshlrev_b32 v14, 16, v14
    v_mul_f32 v6, v14, v9
    v_mul_f32 v7, v15, v9
    v_fma_f32 v14, -v6, v11, v14
    v_fma_f32 v15, -v7, v11, v15
    v_fma_f32 v6, v14, v9, v6
    v_fma_f32 v7, v15, v9, v7
    v_cvt_pk_bf16_f32 v38, v6, v7
    v_lshlrev_b32 v14, 16, v39
    v_and_b32 v15, 0xffff0000, v39
    v_sub_f32 v14, v14, v12
    v_sub_f32 v15, v15, v12
    v_cvt_pk_bf16_f32 v14, v14, v15
    v_and_b32 v15, 0xffff0000, v14
    v_lshlrev_b32 v14, 16, v14
    v_mul_f32 v6, v14, v9
    v_mul_f32 v7, v15, v9
    v_fma_f32 v14, -v6, v11, v14
    v_fma_f32 v15, -v7, v11, v15
    v_fma_f32 v6, v14, v9, v6
    v_fma_f32 v7, v15, v9, v7
    v_cvt_pk_bf16_f32 v39, v6, v7
    v_lshlrev_b32 v14, 16, v40
    v_and_b32 v15, 0xffff0000, v40
    v_sub_f32 v14, v14, v12
    v_sub_f32 v15, v15, v12
    v_cvt_pk_bf16_f32 v14, v14, v15
    v_and_b32 v15, 0xffff0000, v14
    v_lshlrev_b32 v14, 16, v14
    v_mul_f32 v6, v14, v9
    v_mul_f32 v7, v15, v9
    v_fma_f32 v14, -v6, v11, v14
    v_fma_f32 v15, -v7, v11, v15
    v_fma_f32 v6, v14, v9, v6
    v_fma_f32 v7, v15, v9, v7
    v_cvt_pk_bf16_f32 v40, v6, v7
    v_lshlrev_b32 v14, 16, v41
    v_and_b32 v15, 0xffff0000, v41
    v_sub_f32 v14, v14, v12
    v_sub_f32 v15, v15, v12
    v_cvt_pk_bf16_f32 v14, v14, v15
    v_and_b32 v15, 0xffff0000, v14
    v_lshlrev_b32 v14, 16, v14
    v_mul_f32 v6, v14, v9
    v_mul_f32 v7, v15, v9
    v_fma_f32 v14, -v6, v11, v14
    v_fma_f32 v15, -v7, v11, v15
    v_fma_f32 v6, v14, v9, v6
    v_fma_f32 v7, v15, v9, v7
    v_cvt_pk_bf16_f32 v41, v6, v7
    v_lshlrev_b32 v14, 16, v42
    v_and_b32 v15, 0xffff0000, v42
    v_sub_f32 v14, v14, v12
    v_sub_f32 v15, v15, v12
    v_cvt_pk_bf16_f32 v14, v14, v15
    v_and_b32 v15, 0xffff0000, v14
    v_lshlrev_b32 v14, 16, v14
    v_mul_f32 v6, v14, v9
    v_mul_f32 v7, v15, v9
    v_fma_f32 v14, -v6, v11, v14
    v_fma_f32 v15, -v7, v11, v15
    v_fma_f32 v6, v14, v9, v6
    v_fma_f32 v7, v15, v9, v7
    v_cvt_pk_bf16_f32 v42, v6, v7
    v_lshlrev_b32 v14, 16, v43
    v_and_b32 v15, 0xffff0000, v43
    v_sub_f32 v14, v14, v12
    v_sub_f32 v15, v15, v12
    v_cvt_pk_bf16_f32 v14, v14, v15
    v_and_b32 v15, 0xffff0000, v14
    v_lshlrev_b32 v14, 16, v14
    v_mul_f32 v6, v14, v9
    v_mul_f32 v7, v15, v9
    v_fma_f32 v14, -v6, v11, v14
    v_fma_f32 v15, -v7, v11, v15
    v_fma_f32 v6, v14, v9, v6
    v_fma_f32 v7, v15, v9, v7
    v_cvt_pk_bf16_f32 v43, v6, v7
    v_mov_b32 v10, v243
    s_cmp_ge_u32 s5, 28
    s_cbranch_scc1 L_hdone
    ds_read_b64_tr_b16 v[172:173], v10 offset:16384
    ds_read_b64_tr_b16 v[174:175], v10 offset:16896
    ds_read_b64_tr_b16 v[176:177], v10 offset:20480
    ds_read_b64_tr_b16 v[178:179], v10 offset:20992
    s_waitcnt lgkmcnt(0)
    v_mfma_f32_16x16x32_bf16 v[220:223], v[36:39], v[172:175], 0
    v_mfma_f32_16x16x32_bf16 v[220:223], v[40:43], v[176:179], v[220:223]
    s_nop 7
    v_cndmask_b32 v224, v220, v221, s[20:21]
    v_cndmask_b32 v224, v224, v222, s[22:23]
    v_cndmask_b32 v224, v224, v223, s[24:25]
    buffer_store_dwordx2 v[224:225], v245, s[88:91], s31 offen sc1
L_hdone:
    v_xor_b32 v6, v3, v2
    v_lshlrev_b32 v6, 4, v6
    v_lshl_add_u32 v6, v3, 8, v6
    s_lshl_b32 s17, s8, 13
    s_add_u32 s17, s17, 24576
    v_add_u32 v6, s17, v6
    v_lshrrev_b32 v8, 2, v1
    v_and_b32 v9, 7, v8
    v_lshlrev_b32 v9, 5, v9
    v_lshl_add_u32 v9, v8, 8, v9
    v_lshl_add_u32 v9, v4, 3, v9
    s_lshl_b32 s17, s8, 13
    s_add_u32 s17, s17, 57344
    v_add_u32 v9, s17, v9
    s_mov_b32 s12, 0
    buffer_load_dwordx4 v[156:159], v246, s[88:91], s26 offen sc1
    buffer_load_dwordx4 v[160:163], v246, s[88:91], s27 offen sc1
    buffer_load_dwordx4 v[164:167], v246, s[88:91], s28 offen sc1
    buffer_load_dwordx4 v[168:171], v246, s[88:91], s29 offen sc1
    v_mov_b32 v240, v6
    v_mov_b32 v241, v9
    v_lshlrev_b32 v7, 1, v2
    v_xor_b32 v5, v3, v7
    v_xor_b32 v6, 8, v5
    s_and_b32 s14, s8, 1
    s_lshl_b32 s14, s14, 3
    v_xor_b32 v7, s14, v5
    v_lshlrev_b32 v5, 4, v5
    v_lshlrev_b32 v6, 4, v6
    v_lshlrev_b32 v7, 4, v7
    v_lshl_add_u32 v5, v2, 10, v5
    v_lshl_add_u32 v6, v2, 10, v6
    v_lshl_add_u32 v7, v2, 10, v7
    s_lshl_b32 s15, s10, 8
    s_lshl_b32 s16, s9, 16
    s_add_u32 s16, s16, s15
    s_lshl_b32 s17, s8, 14
    s_add_u32 s16, s16, s17
    s_lshl_b32 s18, s8, 12
    s_add_u32 s18, s18, 90112
    s_mul_i32 s19, s9, 28672
    s_add_u32 s19, s19, s15
    s_lshl_b32 s17, s8, 13
    s_add_u32 s19, s19, s17
    s_lshl_b32 s17, s8, 11
    s_add_u32 s17, s17, 106496
    s_mov_b32 m0, s18
    s_nop 0
    buffer_load_dwordx4 v5, s[60:63], s16 offen nt lds
    s_add_u32 s16, s16, 4096
    s_add_u32 s18, s18, 1024
    s_mov_b32 m0, s18
    s_nop 0
    buffer_load_dwordx4 v5, s[60:63], s16 offen nt lds
    s_add_u32 s16, s16, 4096
    s_add_u32 s18, s18, 1024
    s_mov_b32 m0, s18
    s_nop 0
    buffer_load_dwordx4 v6, s[60:63], s16 offen nt lds
    s_add_u32 s16, s16, 4096
    s_add_u32 s18, s18, 1024
    s_mov_b32 m0, s18
    s_nop 0
    buffer_load_dwordx4 v6, s[60:63], s16 offen nt lds
    s_mov_b32 m0, s17
    s_nop 0
    buffer_load_dwordx4 v7, s[72:75], s19 offen nt lds
    s_add_u32 s19, s19, 4096
    s_add_u32 s17, s17, 1024
    s_mov_b32 m0, s17
    s_nop 0
    buffer_load_dwordx4 v7, s[72:75], s19 offen nt lds
    v_mov_b32 v6, v240
    v_mov_b32 v9, v241
    s_waitcnt vmcnt(6)
    ds_read_b128 v[76:79], v6 offset:0
    ds_read_b128 v[92:95], v6 offset:4096
    v_xor_b32 v7, 64, v6
    ds_read_b128 v[80:83], v7 offset:0
    ds_read_b128 v[96:99], v7 offset:4096
    v_xor_b32 v7, 128, v6
    ds_read_b128 v[84:87], v7 offset:0
    ds_read_b128 v[100:103], v7 offset:4096
    v_xor_b32 v7, 192, v6
    ds_read_b128 v[88:91], v7 offset:0
    ds_read_b128 v[104:107], v7 offset:4096
    ds_read_b64_tr_b16 v[108:109], v9
    ds_read_b64_tr_b16 v[110:111], v9 offset:4096
    v_xor_b32 v7, 32, v9
    ds_read_b64_tr_b16 v[112:113], v7
    ds_read_b64_tr_b16 v[114:115], v7 offset:4096
    v_xor_b32 v7, 64, v9
    ds_read_b64_tr_b16 v[116:117], v7
    ds_read_b64_tr_b16 v[118:119], v7 offset:4096
    v_xor_b32 v7, 96, v9
    ds_read_b64_tr_b16 v[120:121], v7
    ds_read_b64_tr_b16 v[122:123], v7 offset:4096
    v_xor_b32 v7, 128, v9
    ds_read_b64_tr_b16 v[124:125], v7
    ds_read_b64_tr_b16 v[126:127], v7 offset:4096
    v_xor_b32 v7, 160, v9
    ds_read_b64_tr_b16 v[128:129], v7
    ds_read_b64_tr_b16 v[130:131], v7 offset:4096
    v_xor_b32 v7, 192, v9
    ds_read_b64_tr_b16 v[132:133], v7
    ds_read_b64_tr_b16 v[134:135], v7 offset:4096
    v_xor_b32 v7, 224, v9
    ds_read_b64_tr_b16 v[136:137], v7
    ds_read_b64_tr_b16 v[138:139], v7 offset:4096
    v_min3_u32 v10, v157, v159, v161
    v_min3_u32 v10, v10, v163, v165
    v_min3_u32 v10, v10, v167, v169
    v_min_u32 v10, v10, v171
    v_max3_u32 v11, v157, v159, v161
    v_max3_u32 v11, v11, v163, v165
    v_max3_u32 v11, v11, v167, v169
    v_max_u32 v11, v11, v171
    v_xor_b32 v10, s11, v10
    v_xor_b32 v11, s11, v11
    v_or_b32 v10, v10, v11
    v_cmp_ne_u32 vcc, 0, v10
    s_cbranch_vccz L_p1d
L_p1:
    buffer_load_dwordx4 v[156:159], v246, s[88:91], s26 offen sc1
    buffer_load_dwordx4 v[160:163], v246, s[88:91], s27 offen sc1
    buffer_load_dwordx4 v[164:167], v246, s[88:91], s28 offen sc1
    buffer_load_dwordx4 v[168:171], v246, s[88:91], s29 offen sc1
    s_waitcnt vmcnt(0)
    v_min3_u32 v10, v157, v159, v161
    v_min3_u32 v10, v10, v163, v165
    v_min3_u32 v10, v10, v167, v169
    v_min_u32 v10, v10, v171
    v_max3_u32 v11, v157, v159, v161
    v_max3_u32 v11, v11, v163, v165
    v_max3_u32 v11, v11, v167, v169
    v_max_u32 v11, v11, v171
    v_xor_b32 v10, s11, v10
    v_xor_b32 v11, s11, v11
    v_or_b32 v10, v10, v11
    v_cmp_ne_u32 vcc, 0, v10
    s_add_u32 s12, s12, 1
    s_cmp_lt_u32 s12, 20000
    s_cbranch_scc0 L_p1d
    s_cbranch_vccnz L_p1
L_p1d:
    v_add_f32 v10, v156, v160
    v_add_f32 v11, v158, v162
    v_add_f32 v12, v164, v168
    v_add_f32 v13, v166, v170
    v_add_f32 v10, v10, v12
    v_add_f32 v11, v11, v13
    v_cvt_pk_bf16_f32 v10, v10, v11
    v_lshlrev_b32 v11, 2, v0
    v_add_u32 v11, 114688, v11
    ds_write_b32 v11, v10
    v_lshlrev_b32 v12, 8, v4
    v_lshl_add_u32 v12, v2, 4, v12
    v_add_u32 v12, 114688, v12
    s_waitcnt lgkmcnt(0)
    s_barrier
    ds_read_b128 v[140:143], v12 offset:0
    ds_read_b128 v[144:147], v12 offset:64
    ds_read_b128 v[148:151], v12 offset:128
    ds_read_b128 v[152:155], v12 offset:192
    s_waitcnt lgkmcnt(0)
    v_mfma_f32_16x16x32_bf16 v[220:223], v[76:79], v[140:143], 0
    v_mfma_f32_16x16x32_bf16 v[220:223], v[80:83], v[144:147], v[220:223]
    v_mfma_f32_16x16x32_bf16 v[220:223], v[84:87], v[148:151], v[220:223]
    v_mfma_f32_16x16x32_bf16 v[220:223], v[88:91], v[152:155], v[220:223]
    v_mfma_f32_16x16x32_bf16 v[224:227], v[92:95], v[140:143], 0
    v_mfma_f32_16x16x32_bf16 v[224:227], v[96:99], v[144:147], v[224:227]
    v_mfma_f32_16x16x32_bf16 v[224:227], v[100:103], v[148:151], v[224:227]
    v_mfma_f32_16x16x32_bf16 v[224:227], v[104:107], v[152:155], v[224:227]
    s_nop 7
    v_cvt_pk_bf16_f32 v14, v220, v221
    v_and_b32 v15, 0xffff0000, v14
    v_lshlrev_b32 v14, 16, v14
    v_mul_f32 v14, 0x3db504f3, v14
    v_mul_f32 v15, 0x3db504f3, v15
    v_cvt_pk_bf16_f32 v14, v14, v15
    v_and_b32 v15, 0xffff0000, v14
    v_lshlrev_b32 v14, 16, v14
    v_mul_f32 v220, 0x3fb8aa3b, v14
    v_mul_f32 v221, 0x3fb8aa3b, v15
    v_cvt_pk_bf16_f32 v14, v222, v223
    v_and_b32 v15, 0xffff0000, v14
    v_lshlrev_b32 v14, 16, v14
    v_mul_f32 v14, 0x3db504f3, v14
    v_mul_f32 v15, 0x3db504f3, v15
    v_cvt_pk_bf16_f32 v14, v14, v15
    v_and_b32 v15, 0xffff0000, v14
    v_lshlrev_b32 v14, 16, v14
    v_mul_f32 v222, 0x3fb8aa3b, v14
    v_mul_f32 v223, 0x3fb8aa3b, v15
    v_cvt_pk_bf16_f32 v14, v224, v225
    v_and_b32 v15, 0xffff0000, v14
    v_lshlrev_b32 v14, 16, v14
    v_mul_f32 v14, 0x3db504f3, v14
    v_mul_f32 v15, 0x3db504f3, v15
    v_cvt_pk_bf16_f32 v14, v14, v15
    v_and_b32 v15, 0xffff0000, v14
    v_lshlrev_b32 v14, 16, v14
    v_mul_f32 v224, 0x3fb8aa3b, v14
    v_mul_f32 v225, 0x3fb8aa3b, v15
    v_cvt_pk_bf16_f32 v14, v226, v227
    v_and_b32 v15, 0xffff0000, v14
    v_lshlrev_b32 v14, 16, v14
    v_mul_f32 v14, 0x3db504f3, v14
    v_mul_f32 v15, 0x3db504f3, v15
    v_cvt_pk_bf16_f32 v14, v14, v15
    v_and_b32 v15, 0xffff0000, v14
    v_lshlrev_b32 v14, 16, v14
    v_mul_f32 v226, 0x3fb8aa3b, v14
    v_mul_f32 v227, 0x3fb8aa3b, v15
    v_max3_f32 v12, v220, v221, v222
    v_max3_f32 v12, v12, v223, v224
    v_max3_f32 v12, v12, v225, v226
    v_max_f32 v12, v12, v227
    v_mov_b32 v14, v12
    s_nop 1
    v_permlane16_swap_b32 v12, v14
    v_max_f32 v12, v12, v14
    v_mov_b32 v14, v12
    s_nop 1
    v_permlane32_swap_b32 v12, v14
    v_max_f32 v12, v12, v14
    v_sub_f32 v220, v220, v12
    v_sub_f32 v221, v221, v12
    v_sub_f32 v222, v222, v12
    v_sub_f32 v223, v223, v12
    v_sub_f32 v224, v224, v12
    v_sub_f32 v225, v225, v12
    v_sub_f32 v226, v226, v12
    v_sub_f32 v227, v227, v12
    v_exp_f32 v220, v220
    v_exp_f32 v221, v221
    v_exp_f32 v222, v222
    v_exp_f32 v223, v223
    v_exp_f32 v224, v224
    v_exp_f32 v225, v225
    v_exp_f32 v226, v226
    v_exp_f32 v227, v227
    s_nop 0
    v_cvt_pk_bf16_f32 v228, v220, v221
    v_cvt_pk_bf16_f32 v229, v222, v223
    v_cvt_pk_bf16_f32 v230, v224, v225
    v_cvt_pk_bf16_f32 v231, v226, v227
    v_add_f32 v13, v220, v221
    s_nop 0
    v_mfma_f32_16x16x32_bf16 v[156:159], v[108:111], v[228:231], 0
    v_mfma_f32_16x16x32_bf16 v[160:163], v[112:115], v[228:231], 0
    v_mfma_f32_16x16x32_bf16 v[164:167], v[116:119], v[228:231], 0
    v_mfma_f32_16x16x32_bf16 v[168:171], v[120:123], v[228:231], 0
    v_mfma_f32_16x16x32_bf16 v[172:175], v[124:127], v[228:231], 0
    v_mfma_f32_16x16x32_bf16 v[176:179], v[128:131], v[228:231], 0
    v_mfma_f32_16x16x32_bf16 v[180:183], v[132:135], v[228:231], 0
    v_mfma_f32_16x16x32_bf16 v[184:187], v[136:139], v[228:231], 0
    v_add_f32 v13, v13, v222
    v_add_f32 v13, v13, v223
    v_add_f32 v13, v13, v224
    v_add_f32 v13, v13, v225
    v_add_f32 v13, v13, v226
    v_add_f32 v13, v13, v227
    v_mov_b32 v14, v13
    s_nop 1
    v_permlane16_swap_b32 v13, v14
    v_add_f32 v13, v13, v14
    v_mov_b32 v14, v13
    s_nop 1
    v_permlane32_swap_b32 v13, v14
    v_add_f32 v13, v13, v14
    s_mul_i32 s13, s8, 2112
    s_add_u32 s13, s13, 118784
    v_mul_u32_u24 v5, 528, v4
    v_lshl_add_u32 v5, v2, 4, v5
    v_add_u32 v5, s13, v5
    s_lshl_b32 s13, s8, 5
    s_add_u32 s13, s13, 115712
    v_lshlrev_b32 v6, 3, v4
    v_add_u32 v6, s13, v6
    s_mov_b32 exec_lo, 0x000f000f
    s_mov_b32 exec_hi, 0x000f000f
    ds_write_b64 v6, v[12:13]
    ds_write_b128 v5, v[156:159] offset:0
    ds_write_b128 v5, v[160:163] offset:64
    ds_write_b128 v5, v[164:167] offset:128
    ds_write_b128 v5, v[168:171] offset:192
    ds_write_b128 v5, v[172:175] offset:256
    ds_write_b128 v5, v[176:179] offset:320
    ds_write_b128 v5, v[180:183] offset:384
    ds_write_b128 v5, v[184:187] offset:448
    s_mov_b64 exec, -1
    s_mul_i32 s13, s8, 528
    s_add_u32 s13, s13, 118784
    v_lshlrev_b32 v5, 3, v1
    v_add_u32 v5, s13, v5
    s_lshl_b32 s13, s8, 3
    s_add_u32 s13, s13, 115712
    v_mov_b32 v6, s13
    s_waitcnt lgkmcnt(0)
    s_barrier
    ds_read_b64 v[228:229], v6 offset:0
    ds_read_b64 v[230:231], v6 offset:32
    ds_read_b64 v[232:233], v6 offset:64
    ds_read_b64 v[234:235], v6 offset:96
    ds_read_b64 v[220:221], v5 offset:0
    ds_read_b64 v[222:223], v5 offset:2112
    ds_read_b64 v[224:225], v5 offset:4224
    ds_read_b64 v[226:227], v5 offset:6336
    v_mov_b32 v237, s11
    v_mov_b32 v239, s11
    v_mov_b32 v241, s11
    v_mov_b32 v243, s11
    s_waitcnt lgkmcnt(4)
    v_max3_f32 v240, v228, v230, v232
    v_max_f32 v240, v240, v234
    v_sub_f32 v228, v228, v240
    v_sub_f32 v230, v230, v240
    v_sub_f32 v232, v232, v240
    v_sub_f32 v234, v234, v240
    v_exp_f32 v228, v228
    v_exp_f32 v230, v230
    v_exp_f32 v232, v232
    v_exp_f32 v234, v234
    s_waitcnt lgkmcnt(0)
    v_mul_f32 v236, v228, v220
    v_mul_f32 v238, v228, v221
    v_mul_f32 v242, v228, v229
    v_fmac_f32 v236, v230, v222
    v_fmac_f32 v238, v230, v223
    v_fmac_f32 v242, v230, v231
    v_fmac_f32 v236, v232, v224
    v_fmac_f32 v238, v232, v225
    v_fmac_f32 v242, v232, v233
    v_fmac_f32 v236, v234, v226
    v_fmac_f32 v238, v234, v227
    v_fmac_f32 v242, v234, v235
    buffer_store_dwordx4 v[236:239], v247, s[88:91], s32 offen sc1
    buffer_store_dwordx4 v[240:243], v250, s[88:91], s33 offen sc1
    v_cmp_lt_u32 s[40:41], 27, v1
    s_mov_b32 s12, 0
    v_lshlrev_b32 v5, 1, v1
L_ph:
    s_add_u32 s18, s36, 0
    buffer_load_dwordx2 v[204:205], v248, s[88:91], s18 offen sc1
    s_add_u32 s18, s36, 65536
    buffer_load_dwordx2 v[206:207], v248, s[88:91], s18 offen sc1
    s_add_u32 s18, s36, 131072
    buffer_load_dwordx2 v[208:209], v248, s[88:91], s18 offen sc1
    s_add_u32 s18, s36, 196608
    buffer_load_dwordx2 v[210:211], v248, s[88:91], s18 offen sc1
    s_add_u32 s18, s36, 262144
    buffer_load_dwordx2 v[212:213], v248, s[88:91], s18 offen sc1
    s_add_u32 s18, s36, 327680
    buffer_load_dwordx2 v[214:215], v248, s[88:91], s18 offen sc1
    s_add_u32 s18, s36, 393216
    buffer_load_dwordx2 v[216:217], v248, s[88:91], s18 offen sc1
    s_add_u32 s18, s36, 458752
    buffer_load_dwordx2 v[218:219], v248, s[88:91], s18 offen sc1
    v_mov_b32 v9, s11
    s_waitcnt vmcnt(0)
    v_cndmask_b32 v205, v205, v9, s[40:41]
    v_cndmask_b32 v207, v207, v9, s[40:41]
    v_cndmask_b32 v209, v209, v9, s[40:41]
    v_cndmask_b32 v211, v211, v9, s[40:41]
    v_cndmask_b32 v213, v213, v9, s[40:41]
    v_cndmask_b32 v215, v215, v9, s[40:41]
    v_cndmask_b32 v217, v217, v9, s[40:41]
    v_cndmask_b32 v219, v219, v9, s[40:41]
    v_min3_u32 v9, v205, v207, v209
    v_min3_u32 v9, v9, v211, v213
    v_min3_u32 v9, v9, v215, v217
    v_min_u32 v9, v9, v219
    v_max3_u32 v10, v205, v207, v209
    v_max3_u32 v10, v10, v211, v213
    v_max3_u32 v10, v10, v215, v217
    v_max_u32 v10, v10, v219
    v_xor_b32 v9, s11, v9
    v_xor_b32 v10, s11, v10
    v_or_b32 v9, v9, v10
    v_cmp_ne_u32 vcc, 0, v9
    s_add_u32 s12, s12, 1
    s_cmp_lt_u32 s12, 20000
    s_cbranch_scc0 L_phd
    s_cbranch_vccnz L_ph
L_phd:
    v_and_b32 v11, 7, v1
    v_lshlrev_b32 v11, 4, v11
    s_add_u32 s18, s34, 0
    buffer_load_dwordx2 v[156:157], v248, s[88:91], s18 offen sc1
    s_add_u32 s18, s34, 4096
    buffer_load_dwordx2 v[158:159], v248, s[88:91], s18 offen sc1
    s_add_u32 s18, s34, 8192
    buffer_load_dwordx2 v[160:161], v248, s[88:91], s18 offen sc1
    s_add_u32 s18, s34, 12288
    buffer_load_dwordx2 v[162:163], v248, s[88:91], s18 offen sc1
    s_add_u32 s18, s34, 16384
    buffer_load_dwordx2 v[164:165], v248, s[88:91], s18 offen sc1
    s_add_u32 s18, s34, 20480
    buffer_load_dwordx2 v[166:167], v248, s[88:91], s18 offen sc1
    s_add_u32 s18, s34, 24576
    buffer_load_dwordx2 v[168:169], v248, s[88:91], s18 offen sc1
    s_add_u32 s18, s34, 28672
    buffer_load_dwordx2 v[170:171], v248, s[88:91], s18 offen sc1
    buffer_load_dwordx4 v[172:175], v11, s[88:91], s35 offen sc1
    v_add_f32 v8, v204, v206
    v_add_f32 v8, v8, v208
    v_add_f32 v8, v8, v210
    v_add_f32 v8, v8, v212
    v_add_f32 v8, v8, v214
    v_add_f32 v8, v8, v216
    v_add_f32 v8, v8, v218
    v_cvt_pk_bf16_f32 v9, v8, v8
    v_lshlrev_b32 v8, 16, v9
    v_lshlrev_b32 v9, 16, v17
    v_add_f32 v8, v8, v9
    v_cvt_pk_bf16_f32 v9, v8, v8
    v_lshlrev_b32 v8, 16, v9
    v_mul_f32 v9, v8, v8
    v_mul_f32 v9, 0x3d372713, v9
    v_fma_f32 v9, v9, v8, v8
    v_mul_f32 v9, 0x40135761, v9
    v_exp_f32 v9, v9
    s_nop 0
    v_add_f32 v9, 1.0, v9
    v_rcp_f32 v9, v9
    s_nop 0
    v_fma_f32 v8, -v8, v9, v8
    v_cvt_pk_bf16_f32 v8, v8, v8
    v_cndmask_b32 v8, v8, 0, s[40:41]
    s_lshl_b32 s13, s8, 6
    s_add_u32 s13, s13, 116480
    v_add_u32 v6, s13, v5
    s_mov_b64 exec, 0xffffffff
    ds_write_b16 v6, v8
    s_mov_b64 exec, -1
    v_mov_b32 v13, 0
    v_lshlrev_b32 v14, 16, v60
    v_and_b32 v15, 0xffff0000, v60
    v_lshlrev_b32 v6, 16, v44
    v_and_b32 v7, 0xffff0000, v44
    v_mul_f32 v14, v14, v6
    v_mul_f32 v15, v15, v7
    v_cvt_pk_bf16_f32 v14, v14, v15
    v_and_b32 v15, 0xffff0000, v14
    v_lshlrev_b32 v14, 16, v14
    v_add_f32 v13, v13, v14
    v_add_f32 v13, v13, v15
    v_lshlrev_b32 v14, 16, v61
    v_and_b32 v15, 0xffff0000, v61
    v_lshlrev_b32 v6, 16, v45
    v_and_b32 v7, 0xffff0000, v45
    v_mul_f32 v14, v14, v6
    v_mul_f32 v15, v15, v7
    v_cvt_pk_bf16_f32 v14, v14, v15
    v_and_b32 v15, 0xffff0000, v14
    v_lshlrev_b32 v14, 16, v14
    v_add_f32 v13, v13, v14
    v_add_f32 v13, v13, v15
    v_lshlrev_b32 v14, 16, v62
    v_and_b32 v15, 0xffff0000, v62
    v_lshlrev_b32 v6, 16, v46
    v_and_b32 v7, 0xffff0000, v46
    v_mul_f32 v14, v14, v6
    v_mul_f32 v15, v15, v7
    v_cvt_pk_bf16_f32 v14, v14, v15
    v_and_b32 v15, 0xffff0000, v14
    v_lshlrev_b32 v14, 16, v14
    v_add_f32 v13, v13, v14
    v_add_f32 v13, v13, v15
    v_lshlrev_b32 v14, 16, v63
    v_and_b32 v15, 0xffff0000, v63
    v_lshlrev_b32 v6, 16, v47
    v_and_b32 v7, 0xffff0000, v47
    v_mul_f32 v14, v14, v6
    v_mul_f32 v15, v15, v7
    v_cvt_pk_bf16_f32 v14, v14, v15
    v_and_b32 v15, 0xffff0000, v14
    v_lshlrev_b32 v14, 16, v14
    v_add_f32 v13, v13, v14
    v_add_f32 v13, v13, v15
    v_lshlrev_b32 v14, 16, v64
    v_and_b32 v15, 0xffff0000, v64
    v_lshlrev_b32 v6, 16, v48
    v_and_b32 v7, 0xffff0000, v48
    v_mul_f32 v14, v14, v6
    v_mul_f32 v15, v15, v7
    v_cvt_pk_bf16_f32 v14, v14, v15
    v_and_b32 v15, 0xffff0000, v14
    v_lshlrev_b32 v14, 16, v14
    v_add_f32 v13, v13, v14
    v_add_f32 v13, v13, v15
    v_lshlrev_b32 v14, 16, v65
    v_and_b32 v15, 0xffff0000, v65
    v_lshlrev_b32 v6, 16, v49
    v_and_b32 v7, 0xffff0000, v49
    v_mul_f32 v14, v14, v6
    v_mul_f32 v15, v15, v7
    v_cvt_pk_bf16_f32 v14, v14, v15
    v_and_b32 v15, 0xffff0000, v14
    v_lshlrev_b32 v14, 16, v14
    v_add_f32 v13, v13, v14
    v_add_f32 v13, v13, v15
    v_lshlrev_b32 v14, 16, v66
    v_and_b32 v15, 0xffff0000, v66
    v_lshlrev_b32 v6, 16, v50
    v_and_b32 v7, 0xffff0000, v50
    v_mul_f32 v14, v14, v6
    v_mul_f32 v15, v15, v7
    v_cvt_pk_bf16_f32 v14, v14, v15
    v_and_b32 v15, 0xffff0000, v14
    v_lshlrev_b32 v14, 16, v14
    v_add_f32 v13, v13, v14
    v_add_f32 v13, v13, v15
    v_lshlrev_b32 v14, 16, v67
    v_and_b32 v15, 0xffff0000, v67
    v_lshlrev_b32 v6, 16, v51
    v_and_b32 v7, 0xffff0000, v51
    v_mul_f32 v14, v14, v6
    v_mul_f32 v15, v15, v7
    v_cvt_pk_bf16_f32 v14, v14, v15
    v_and_b32 v15, 0xffff0000, v14
    v_lshlrev_b32 v14, 16, v14
    v_add_f32 v13, v13, v14
    v_add_f32 v13, v13, v15
    v_lshlrev_b32 v14, 16, v68
    v_and_b32 v15, 0xffff0000, v68
    v_lshlrev_b32 v6, 16, v52
    v_and_b32 v7, 0xffff0000, v52
    v_mul_f32 v14, v14, v6
    v_mul_f32 v15, v15, v7
    v_cvt_pk_bf16_f32 v14, v14, v15
    v_and_b32 v15, 0xffff0000, v14
    v_lshlrev_b32 v14, 16, v14
    v_add_f32 v13, v13, v14
    v_add_f32 v13, v13, v15
    v_lshlrev_b32 v14, 16, v69
    v_and_b32 v15, 0xffff0000, v69
    v_lshlrev_b32 v6, 16, v53
    v_and_b32 v7, 0xffff0000, v53
    v_mul_f32 v14, v14, v6
    v_mul_f32 v15, v15, v7
    v_cvt_pk_bf16_f32 v14, v14, v15
    v_and_b32 v15, 0xffff0000, v14
    v_lshlrev_b32 v14, 16, v14
    v_add_f32 v13, v13, v14
    v_add_f32 v13, v13, v15
    v_lshlrev_b32 v14, 16, v70
    v_and_b32 v15, 0xffff0000, v70
    v_lshlrev_b32 v6, 16, v54
    v_and_b32 v7, 0xffff0000, v54
    v_mul_f32 v14, v14, v6
    v_mul_f32 v15, v15, v7
    v_cvt_pk_bf16_f32 v14, v14, v15
    v_and_b32 v15, 0xffff0000, v14
    v_lshlrev_b32 v14, 16, v14
    v_add_f32 v13, v13, v14
    v_add_f32 v13, v13, v15
    v_lshlrev_b32 v14, 16, v71
    v_and_b32 v15, 0xffff0000, v71
    v_lshlrev_b32 v6, 16, v55
    v_and_b32 v7, 0xffff0000, v55
    v_mul_f32 v14, v14, v6
    v_mul_f32 v15, v15, v7
    v_cvt_pk_bf16_f32 v14, v14, v15
    v_and_b32 v15, 0xffff0000, v14
    v_lshlrev_b32 v14, 16, v14
    v_add_f32 v13, v13, v14
    v_add_f32 v13, v13, v15
    v_lshlrev_b32 v14, 16, v72
    v_and_b32 v15, 0xffff0000, v72
    v_lshlrev_b32 v6, 16, v56
    v_and_b32 v7, 0xffff0000, v56
    v_mul_f32 v14, v14, v6
    v_mul_f32 v15, v15, v7
    v_cvt_pk_bf16_f32 v14, v14, v15
    v_and_b32 v15, 0xffff0000, v14
    v_lshlrev_b32 v14, 16, v14
    v_add_f32 v13, v13, v14
    v_add_f32 v13, v13, v15
    v_lshlrev_b32 v14, 16, v73
    v_and_b32 v15, 0xffff0000, v73
    v_lshlrev_b32 v6, 16, v57
    v_and_b32 v7, 0xffff0000, v57
    v_mul_f32 v14, v14, v6
    v_mul_f32 v15, v15, v7
    v_cvt_pk_bf16_f32 v14, v14, v15
    v_and_b32 v15, 0xffff0000, v14
    v_lshlrev_b32 v14, 16, v14
    v_add_f32 v13, v13, v14
    v_add_f32 v13, v13, v15
    v_lshlrev_b32 v14, 16, v74
    v_and_b32 v15, 0xffff0000, v74
    v_lshlrev_b32 v6, 16, v58
    v_and_b32 v7, 0xffff0000, v58
    v_mul_f32 v14, v14, v6
    v_mul_f32 v15, v15, v7
    v_cvt_pk_bf16_f32 v14, v14, v15
    v_and_b32 v15, 0xffff0000, v14
    v_lshlrev_b32 v14, 16, v14
    v_add_f32 v13, v13, v14
    v_add_f32 v13, v13, v15
    v_lshlrev_b32 v14, 16, v75
    v_and_b32 v15, 0xffff0000, v75
    v_lshlrev_b32 v6, 16, v59
    v_and_b32 v7, 0xffff0000, v59
    v_mul_f32 v14, v14, v6
    v_mul_f32 v15, v15, v7
    v_cvt_pk_bf16_f32 v14, v14, v15
    v_and_b32 v15, 0xffff0000, v14
    v_lshlrev_b32 v14, 16, v14
    v_add_f32 v13, v13, v14
    v_add_f32 v13, v13, v15
    s_nop 1
    v_add_f32_dpp v13, v13, v13 row_ror:4 row_mask:0xf bank_mask:0xf
    s_nop 1
    v_add_f32_dpp v13, v13, v13 row_ror:8 row_mask:0xf bank_mask:0xf
    v_mov_b32 v14, v13
    s_nop 1
    v_permlane16_swap_b32 v13, v14
    v_add_f32 v13, v13, v14
    v_mov_b32 v14, v13
    s_nop 1
    v_permlane32_swap_b32 v13, v14
    v_add_f32 v13, v13, v14
    v_cvt_pk_bf16_f32 v14, v13, v13
    v_lshlrev_b32 v13, 16, v14
    v_mul_f32 v13, 0xbfb8aa3b, v13
    v_exp_f32 v13, v13
    s_nop 0
    v_add_f32 v13, 1.0, v13
    v_rcp_f32 v13, v13
    s_nop 0
    v_cvt_pk_bf16_f32 v14, v13, v13
    v_lshlrev_b32 v16, 16, v14
    s_mov_b32 s12, 0
    s_waitcnt vmcnt(0)
    v_min3_u32 v9, v157, v159, v161
    v_min3_u32 v9, v9, v163, v165
    v_min3_u32 v9, v9, v167, v169
    v_min3_u32 v9, v9, v171, v173
    v_min_u32 v9, v9, v175
    v_max3_u32 v10, v157, v159, v161
    v_max3_u32 v10, v10, v163, v165
    v_max3_u32 v10, v10, v167, v169
    v_max3_u32 v10, v10, v171, v173
    v_max_u32 v10, v10, v175
    v_xor_b32 v9, s11, v9
    v_xor_b32 v10, s11, v10
    v_or_b32 v9, v9, v10
    v_cmp_ne_u32 vcc, 0, v9
    s_cbranch_vccz L_p2d
L_p2:
    s_add_u32 s18, s34, 0
    buffer_load_dwordx2 v[156:157], v248, s[88:91], s18 offen sc1
    s_add_u32 s18, s34, 4096
    buffer_load_dwordx2 v[158:159], v248, s[88:91], s18 offen sc1
    s_add_u32 s18, s34, 8192
    buffer_load_dwordx2 v[160:161], v248, s[88:91], s18 offen sc1
    s_add_u32 s18, s34, 12288
    buffer_load_dwordx2 v[162:163], v248, s[88:91], s18 offen sc1
    s_add_u32 s18, s34, 16384
    buffer_load_dwordx2 v[164:165], v248, s[88:91], s18 offen sc1
    s_add_u32 s18, s34, 20480
    buffer_load_dwordx2 v[166:167], v248, s[88:91], s18 offen sc1
    s_add_u32 s18, s34, 24576
    buffer_load_dwordx2 v[168:169], v248, s[88:91], s18 offen sc1
    s_add_u32 s18, s34, 28672
    buffer_load_dwordx2 v[170:171], v248, s[88:91], s18 offen sc1
    buffer_load_dwordx4 v[172:175], v11, s[88:91], s35 offen sc1
    s_waitcnt vmcnt(0)
    v_min3_u32 v9, v157, v159, v161
    v_min3_u32 v9, v9, v163, v165
    v_min3_u32 v9, v9, v167, v169
    v_min3_u32 v9, v9, v171, v173
    v_min_u32 v9, v9, v175
    v_max3_u32 v10, v157, v159, v161
    v_max3_u32 v10, v10, v163, v165
    v_max3_u32 v10, v10, v167, v169
    v_max3_u32 v10, v10, v171, v173
    v_max_u32 v10, v10, v175
    v_xor_b32 v9, s11, v9
    v_xor_b32 v10, s11, v10
    v_or_b32 v9, v9, v10
    v_cmp_ne_u32 vcc, 0, v9
    s_add_u32 s12, s12, 1
    s_cmp_lt_u32 s12, 20000
    s_cbranch_scc0 L_p2d
    s_cbranch_vccnz L_p2
L_p2d:
    v_mov_b32 v12, v172
    s_nop 1
    v_max_f32_dpp v12, v12, v12 quad_perm:[1,0,3,2] row_mask:0xf bank_mask:0xf
    s_nop 1
    v_max_f32_dpp v12, v12, v12 quad_perm:[2,3,0,1] row_mask:0xf bank_mask:0xf
    s_nop 1
    v_max_f32_dpp v12, v12, v12 row_half_mirror row_mask:0xf bank_mask:0xf
    v_sub_f32 v12, v172, v12
    v_exp_f32 v12, v12
    s_nop 0
    v_mul_f32 v13, v12, v174
    v_readlane_b32 s92, v12, 0
    v_readlane_b32 s93, v12, 1
    v_readlane_b32 s94, v12, 2
    v_readlane_b32 s95, v12, 3
    v_readlane_b32 s96, v12, 4
    v_readlane_b32 s97, v12, 5
    v_readlane_b32 s98, v12, 6
    v_readlane_b32 s99, v12, 7
    s_nop 1
    v_add_f32_dpp v13, v13, v13 quad_perm:[1,0,3,2] row_mask:0xf bank_mask:0xf
    s_nop 1
    v_add_f32_dpp v13, v13, v13 quad_perm:[2,3,0,1] row_mask:0xf bank_mask:0xf
    s_nop 1
    v_add_f32_dpp v13, v13, v13 row_half_mirror row_mask:0xf bank_mask:0xf
    v_mul_f32 v14, s92, v156
    v_fmac_f32 v14, s93, v158
    v_fmac_f32 v14, s94, v160
    v_fmac_f32 v14, s95, v162
    v_fmac_f32 v14, s96, v164
    v_fmac_f32 v14, s97, v166
    v_fmac_f32 v14, s98, v168
    v_fmac_f32 v14, s99, v170
    v_rcp_f32 v15, v13
    s_nop 0
    v_mul_f32 v12, v14, v15
    v_fma_f32 v14, -v12, v13, v14
    v_fma_f32 v12, v14, v15, v12
    v_cvt_pk_bf16_f32 v12, v12, v12
    s_lshl_b32 s13, s8, 7
    s_add_u32 s13, s13, 115968
    v_add_u32 v6, s13, v5
    ds_write_b16 v6, v12
    v_lshlrev_b32 v5, 7, v4
    v_lshl_add_u32 v5, v2, 4, v5
    v_add_u32 v5, 115968, v5
    v_lshlrev_b32 v6, 6, v4
    v_lshl_add_u32 v6, v2, 4, v6
    v_add_u32 v6, 116480, v6
    v_lshl_add_u32 v8, v2, 3, v19
    v_lshlrev_b32 v8, 8, v8
    v_lshl_add_u32 v8, v4, 3, v8
    v_and_b32 v9, 1, v2
    v_lshl_or_b32 v9, v9, 2, v19
    s_lshl_b32 s13, s8, 1
    v_xor_b32 v9, s13, v9
    v_lshl_add_u32 v8, v9, 5, v8
    v_add_u32 v8, 90112, v8
    v_xor_b32 v9, 32, v8
    s_waitcnt lgkmcnt(0)
    s_barrier
    ds_read_b128 v[224:227], v5
    ds_read_b128 v[228:231], v5 offset:64
    ds_read_b128 v[220:223], v6
    ds_read_b64_tr_b16 v[156:157], v8 offset:0
    ds_read_b64_tr_b16 v[158:159], v8 offset:1024
    ds_read_b64_tr_b16 v[160:161], v8 offset:8192
    ds_read_b64_tr_b16 v[162:163], v8 offset:9216
    ds_read_b64_tr_b16 v[172:173], v8 offset:16384
    ds_read_b64_tr_b16 v[174:175], v8 offset:17408
    ds_read_b64_tr_b16 v[164:165], v9 offset:0
    ds_read_b64_tr_b16 v[166:167], v9 offset:1024
    ds_read_b64_tr_b16 v[168:169], v9 offset:8192
    ds_read_b64_tr_b16 v[170:171], v9 offset:9216
    ds_read_b64_tr_b16 v[176:177], v9 offset:16384
    ds_read_b64_tr_b16 v[178:179], v9 offset:17408
    v_mov_b32 v197, s11
    v_mov_b32 v199, s11
    v_mov_b32 v201, s11
    v_mov_b32 v203, s11
    s_waitcnt lgkmcnt(0)
    v_mfma_f32_16x16x32_bf16 v[180:183], v[224:227], v[156:159], 0
    v_mfma_f32_16x16x32_bf16 v[180:183], v[228:231], v[160:163], v[180:183]
    v_mfma_f32_16x16x32_bf16 v[188:191], v[220:223], v[172:175], 0
    v_mfma_f32_16x16x32_bf16 v[184:187], v[224:227], v[164:167], 0
    v_mfma_f32_16x16x32_bf16 v[184:187], v[228:231], v[168:171], v[184:187]
    v_mfma_f32_16x16x32_bf16 v[192:195], v[220:223], v[176:179], 0
    s_nop 4
    v_cndmask_b32 v196, v180, v181, s[20:21]
    v_cndmask_b32 v196, v196, v182, s[22:23]
    v_cndmask_b32 v196, v196, v183, s[24:25]
    v_cndmask_b32 v198, v188, v189, s[20:21]
    v_cndmask_b32 v198, v198, v190, s[22:23]
    v_cndmask_b32 v198, v198, v191, s[24:25]
    buffer_store_dwordx4 v[196:199], v251, s[88:91], s37 offen sc1
    v_cndmask_b32 v200, v184, v185, s[20:21]
    v_cndmask_b32 v200, v200, v186, s[22:23]
    v_cndmask_b32 v200, v200, v187, s[24:25]
    s_nop 0
    v_cndmask_b32 v202, v192, v193, s[20:21]
    v_cndmask_b32 v202, v202, v194, s[22:23]
    v_cndmask_b32 v202, v202, v195, s[24:25]
    buffer_store_dwordx4 v[200:203], v251, s[88:91], s38 offen sc1
    s_lshl_b32 s15, s8, 6
    s_add_u32 s15, s15, 116736
    v_lshlrev_b32 v6, 4, v4
    v_add_u32 v6, s15, v6
    s_mov_b32 s12, 0
L_p3:
    buffer_load_dwordx4 v[156:159], v249, s[88:91], s39 offen sc1
    buffer_load_dwordx4 v[160:163], v249, s[88:91], s39 offen offset:16 sc1
    s_waitcnt vmcnt(0)
    v_min3_u32 v9, v157, v159, v161
    v_min_u32 v9, v9, v163
    v_max3_u32 v10, v157, v159, v161
    v_max_u32 v10, v10, v163
    v_xor_b32 v9, s11, v9
    v_xor_b32 v10, s11, v10
    v_or_b32 v9, v9, v10
    v_cmp_ne_u32 vcc, 0, v9
    s_add_u32 s12, s12, 1
    s_cmp_lt_u32 s12, 20000
    s_cbranch_scc0 L_p3d
    s_cbranch_vccnz L_p3
L_p3d:
    v_mov_b32 v157, v158
    v_mov_b32 v158, v160
    v_mov_b32 v159, v162
    s_nop 1
    v_add_f32_dpp v156, v156, v156 row_ror:4 row_mask:0xf bank_mask:0xf
    v_add_f32_dpp v157, v157, v157 row_ror:4 row_mask:0xf bank_mask:0xf
    v_add_f32_dpp v158, v158, v158 row_ror:4 row_mask:0xf bank_mask:0xf
    v_add_f32_dpp v159, v159, v159 row_ror:4 row_mask:0xf bank_mask:0xf
    v_add_f32_dpp v156, v156, v156 row_ror:8 row_mask:0xf bank_mask:0xf
    v_add_f32_dpp v157, v157, v157 row_ror:8 row_mask:0xf bank_mask:0xf
    v_add_f32_dpp v158, v158, v158 row_ror:8 row_mask:0xf bank_mask:0xf
    v_add_f32_dpp v159, v159, v159 row_ror:8 row_mask:0xf bank_mask:0xf
    v_mov_b32 v164, v156
    v_mov_b32 v165, v157
    v_mov_b32 v166, v158
    v_mov_b32 v167, v159
    v_permlane16_swap_b32 v156, v164
    v_permlane16_swap_b32 v157, v165
    v_permlane16_swap_b32 v158, v166
    v_permlane16_swap_b32 v159, v167
    v_add_f32 v156, v156, v164
    v_add_f32 v157, v157, v165
    v_add_f32 v158, v158, v166
    v_add_f32 v159, v159, v167
    v_mov_b32 v164, v156
    v_mov_b32 v165, v157
    v_mov_b32 v166, v158
    v_mov_b32 v167, v159
    v_permlane32_swap_b32 v156, v164
    v_permlane32_swap_b32 v157, v165
    v_permlane32_swap_b32 v158, v166
    v_permlane32_swap_b32 v159, v167
    v_add_f32 v156, v156, v164
    v_add_f32 v157, v157, v165
    v_add_f32 v158, v158, v166
    v_add_f32 v159, v159, v167
    ds_write_b128 v6, v[156:159]
    s_waitcnt lgkmcnt(0)
    s_barrier
    s_cmp_lg_u32 s8, 0
    s_cbranch_scc1 L_end
    v_and_b32 v5, 7, v1
    v_lshlrev_b32 v5, 3, v5
    v_add_u32 v5, 116736, v5
    ds_read_b64 v[156:157], v5 offset:0
    ds_read_b64 v[158:159], v5 offset:64
    ds_read_b64 v[160:161], v5 offset:128
    ds_read_b64 v[162:163], v5 offset:192
    s_lshl_b32 s13, s10, 8
    s_lshl_b32 s14, s9, 2
    s_add_u32 s13, s13, s14
    v_and_b32 v6, 1, v19
    v_lshlrev_b32 v6, 1, v6
    v_lshl_add_u32 v6, v4, 10, v6
    v_sub_f32 v12, 1.0, v16
    v_cvt_pk_bf16_f32 v15, v12, v12
    v_lshlrev_b32 v12, 16, v15
    v_lshlrev_b32 v11, 16, v18
    s_waitcnt lgkmcnt(0)
    v_add_f32 v13, v156, v158
    v_add_f32 v14, v157, v159
    v_add_f32 v13, v13, v160
    v_add_f32 v14, v14, v161
    v_add_f32 v13, v13, v162
    v_add_f32 v14, v14, v163
    v_cvt_pk_bf16_f32 v15, v13, v13
    v_lshlrev_b32 v13, 16, v15
    v_cvt_pk_bf16_f32 v15, v14, v14
    v_lshlrev_b32 v14, 16, v15
    v_add_f32 v14, v14, v11
    v_cvt_pk_bf16_f32 v15, v14, v14
    v_lshlrev_b32 v14, 16, v15
    v_mul_f32 v13, v16, v13
    v_cvt_pk_bf16_f32 v15, v13, v13
    v_lshlrev_b32 v13, 16, v15
    v_mul_f32 v14, v12, v14
    v_cvt_pk_bf16_f32 v15, v14, v14
    v_lshlrev_b32 v14, 16, v15
    v_add_f32 v13, v13, v14
    v_cvt_pk_bf16_f32 v13, v13, v13
    s_mov_b64 exec, 0xff
    buffer_store_short v13, v6, s[84:87], s13 offen
    s_mov_b64 exec, -1
    s_cmp_lg_u32 s2, 0
    s_cbranch_scc1 L_end
    v_mov_b32 v5, 0
    v_mov_b32 v6, s11
    buffer_store_dword v6, v5, s[88:91], 0 offen
L_end:
    s_endpgm
.section .rodata,"a"
.p2align 6
.amdhsa_kernel gated_mix__sliding_block_cached__mixer_channel_mlp__decode_kernel
  .amdhsa_next_free_vgpr 256
  .amdhsa_next_free_sgpr 102
  .amdhsa_accum_offset 256
  .amdhsa_group_segment_fixed_size 0
  .amdhsa_kernarg_size 112
  .amdhsa_user_sgpr_count 2
  .amdhsa_user_sgpr_kernarg_segment_ptr 1
  .amdhsa_system_sgpr_workgroup_id_x 1
  .amdhsa_float_denorm_mode_32 3
.end_amdhsa_kernel
```
